```python
import torch

def _softmax(x, axis=-1):
    return torch.softmax(x, dim=axis)
def _gelu(x):
    return torch.nn.functional.gelu(x, approximate="tanh")
def _silu(x):
    return torch.nn.functional.silu(x)
def _sigmoid(x):
    return torch.sigmoid(x)
def _layernorm(x, axis=-1, eps=1e-5):
    m = x.mean(dim=axis, keepdim=True)
    v = x.var(dim=axis, keepdim=True, unbiased=False)
    return (x - m) / torch.sqrt(v + eps)
def _scatter_add(tgt, idx, src, axis=0):
    return tgt.clone().index_add_(axis, idx, src)
def _segment_sum(src, seg, n):
    out = torch.zeros((n,) + src.shape[1:], dtype=src.dtype)
    return out.index_add_(0, seg, src)
def _pad(x, pw):
    flat = tuple(v for pair in reversed(pw) for v in pair)
    return torch.nn.functional.pad(x, flat)

kernel_name = 'standalone__paged_block_table_kv_pagedattention__sampling'

def setup_inputs():

    _w = (lambda a: (lambda t: t.to(torch.bfloat16) if t.is_floating_point() else t)(torch.as_tensor(a)))
    B, Hq, Hkv, Sq, Skv, D = 32, 32, 4, 1, 2048, 128
    bs = 16
    nbps = max(1, Skv // bs)
    num_phys = B * nbps + 4
    bt = torch.randperm(num_phys)[: B * nbps].reshape(B, nbps).to(torch.int64)
    cl = (nbps * bs - (torch.arange(1, B + 1, dtype=torch.int64) * 2654435761) % max(1, nbps * bs // 2)).to(torch.int64)
    return {
        "q": _w((lambda *s: torch.randn(*s, dtype=torch.bfloat16) * 0.8)(B, Hq, Sq, D)),
        "k_cache": _w((lambda *s: torch.randn(*s, dtype=torch.bfloat16) * 0.8)(num_phys, bs, Hkv, D)),
        "v_cache": _w((lambda *s: torch.randn(*s, dtype=torch.bfloat16) * 0.05)(num_phys, bs, Hkv, D)),
        "block_table": _w(bt),
        "context_lens": _w(cl),
    }

def reference(q, k_cache, v_cache, block_table, context_lens):
    B, Hq, Sq, D = q.shape
    bs = k_cache.shape[1]
    Hkv = k_cache.shape[2]
    nbps = block_table.shape[1]
    Skv = nbps * bs
    bt = block_table.reshape(-1)
    k = (lambda x, *d: x.permute(*d))(k_cache[bt].reshape(B, Skv, Hkv, D), 0, 2, 1, 3)
    v = (lambda x, *d: x.permute(*d))(v_cache[bt].reshape(B, Skv, Hkv, D), 0, 2, 1, 3)
    g = Hq // Hkv
    qg = q.reshape(B, Hkv, g, Sq, D)
    scores = torch.einsum("bhgqd,bhkd->bhgqk", qg, k) * (D ** -0.5)
    pos = torch.arange(Skv)
    msk = pos[None, :] < context_lens[:, None]
    scores = torch.where(msk[:, None, None, None, :], scores, -1e9)
    p = _softmax(scores, axis=-1)
    out = torch.einsum("bhgqk,bhkd->bhgqd", p, v)
    return out.reshape(B, Hq, Sq, D)
```

```asm
; @launch grid=(256,1,1) block=(256,1,1) lds=98816
.amdgcn_target "amdgcn-amd-amdhsa--gfx950"
.text
.globl standalone__paged_block_table_kv_pagedattention__sampling_kernel
.p2align 8
.type standalone__paged_block_table_kv_pagedattention__sampling_kernel,@function
standalone__paged_block_table_kv_pagedattention__sampling_kernel:
    s_cmp_ge_u32 s2, 256
    s_cbranch_scc1 L_EXIT
    s_load_dwordx16 s[4:19], s[0:1], 0
    v_and_b32 v1, 63, v0
    v_lshrrev_b32 v34, 6, v0
    s_lshr_b32 s3, s2, 4
    s_lshl_b32 s3, s3, 3
    s_and_b32 s50, s2, 7
    s_or_b32 s50, s50, s3
    v_readfirstlane_b32 s28, v34
    s_bitcmp1_b32 s2, 3
    s_cbranch_scc1 L_PPRO
    s_bfe_u32 s49, s50, 0x20003
    s_lshr_b32 s3, s50, 2
    s_and_b32 s3, s3, 0x18
    s_and_b32 s48, s50, 7
    s_or_b32 s48, s48, s3
    s_mov_b32 s51, 0x6064736
    s_cmp_eq_u32 s49, 1
    s_cselect_b32 s51, 0x4043524, s51
    s_cmp_eq_u32 s49, 2
    s_cselect_b32 s51, 0x6064736, s51
    s_cmp_eq_u32 s49, 3
    s_cselect_b32 s51, 0x6064736, s51
    s_lshl_b32 s47, s49, 3
    s_lshr_b32 s46, 0x35372738, s47
    s_and_b32 s46, s46, 0xff
    s_lshl_b32 s3, s48, 2
    s_lshr_b32 s3, s51, s3
    s_and_b32 s3, s3, 15
    s_add_u32 s34, s3, s46
    s_mul_i32 s33, s34, s28
    s_add_u32 s34, s34, s33
    s_lshr_b32 s37, s33, 2
    s_and_b32 s42, s33, 3
    s_lshl_b32 s3, s48, 7
    s_add_u32 s3, s3, s37
    v_add_u32 v36, s3, v1
    v_and_b32 v36, 0xfff, v36
    v_lshlrev_b32 v36, 2, v36
    v_lshrrev_b32 v40, 4, v1
    v_and_b32 v45, 7, v1
    v_and_b32 v41, 15, v1
    v_lshlrev_b32 v42, 1, v40
    v_xor_b32 v42, v41, v42
    v_xor_b32 v43, 8, v42
    v_lshlrev_b32 v44, 10, v40
    v_lshl_add_u32 v2, v42, 4, v44
    v_lshl_add_u32 v3, v43, 4, v44
    v_add_u32 v4, 6144, v2
    v_add_u32 v5, 9216, v3
    v_add_u32 v3, 3072, v3
    v_and_b32 v35, 31, v1
    v_lshlrev_b32 v38, 2, v35
    s_lshl_b32 s3, s49, 7
    s_add_u32 s3, s3, 0x3f0000
    v_add_u32 v156, s3, v38
    s_lshl_b32 s3, s49, 11
    v_lshl_add_u32 v155, v45, 8, s3
    v_lshl_add_u32 v155, v40, 4, v155
    s_lshl_b32 s44, s28, 14
    v_lshl_add_u32 v39, v1, 4, s44
    v_mov_b32 v112, 0
    v_mov_b32 v113, 0
    v_mov_b32 v114, 0
    v_mov_b32 v115, 0
    s_mov_b32 s22, 0x4010000
    s_mov_b32 s23, 0x00020000
    s_mov_b32 s26, 0x4010000
    s_mov_b32 s27, 0x00020000
    s_lshl_b32 s60, s49, 8
    s_lshl_b32 s3, s48, 13
    v_add_u32 v58, s3, v155
    s_mov_b32 m0, s44
    s_waitcnt lgkmcnt(0)
    global_load_dword v18, v36, s[10:11]
    s_mov_b32 s20, s6
    s_and_b32 s21, s7, 0xffff
    s_mov_b32 s24, s8
    s_and_b32 s25, s9, 0xffff
    ds_write_b128 v39, v[112:115] offset:4096
    ds_write_b128 v39, v[112:115] offset:5120
    ds_write_b128 v39, v[112:115] offset:6144
    global_load_dwordx4 v[80:83], v58, s[4:5] offset:0
    global_load_dwordx4 v[84:87], v58, s[4:5] offset:64
    global_load_dwordx4 v[88:91], v58, s[4:5] offset:128
    global_load_dwordx4 v[92:95], v58, s[4:5] offset:192
    global_load_dword v37, v38, s[12:13]
    global_load_dword v25, v156, s[18:19]
    v_lshlrev_b32 v43, 2, v1
    v_bfe_u32 v46, s51, v43, 4
    v_add3_u32 v46, v46, s46, -1
    v_lshl_add_u32 v47, v35, 7, v46
    v_add_u32 v47, 1, v47
    s_lshr_b32 s62, 0x644a1900, s47
    s_and_b32 s62, s62, 0xff
    s_lshr_b32 s3, 0x1c1a3119, s47
    s_and_b32 s3, s3, 0xff
    v_min_u32 v42, s3, v1
    v_add_lshl_u32 v43, v42, s62, 3
    s_mov_b32 s52, 0x88828480
    s_mov_b32 s53, 0x88848c88
    v_lshrrev_b64 v[52:53], v43, s[52:53]
    s_lshl_b32 s3, s62, 3
    s_lshr_b64 s[52:53], s[52:53], s3
    s_and_b32 s52, s52, 0xff
    v_and_b32 v52, 0xff, v52
    v_lshl_add_u32 v52, v42, 7, v52
    v_subrev_u32 v52, s52, v52
    s_lshl_b32 s3, s49, 4
    s_mov_b32 s52, 0x539fa3a3
    s_mov_b32 s53, 0x929d9d42
    s_lshr_b64 s[52:53], s[52:53], s3
    s_and_b32 s52, s52, 0xffff
    v_mul_u32_u24 v52, s52, v52
    v_lshrrev_b32 v63, 8, v52
    s_mov_b32 s52, 0x5d6026a
    s_mov_b32 s53, 0x2cf028c
    s_lshr_b64 s[52:53], s[52:53], s3
    s_and_b32 s31, s52, 0xffff
    v_mov_b32 v22, 0x3e0293ee
    s_cmp_gt_u32 s42, 0
    s_cselect_b32 s52, 0x40000000, 0
    s_cmp_gt_u32 s42, 1
    s_cselect_b32 s53, 0x40000000, 0
    s_cmp_gt_u32 s42, 2
    s_cselect_b32 s54, 0x40000000, 0
    s_waitcnt vmcnt(6) lgkmcnt(0)
    v_lshl_add_u32 v18, v18, 14, s60
    s_nop 0
    v_readlane_b32 s55, v18, 0
    v_readlane_b32 s64, v18, 1
    s_or_b32 s52, s52, s55
    s_or_b32 s53, s53, s55
    s_or_b32 s54, s54, s55
    buffer_load_dwordx4 v2, s[20:23], s52 offen offset:0 nt lds
    buffer_load_dwordx4 v3, s[20:23], s53 offen offset:1024 nt lds
    buffer_load_dwordx4 v4, s[20:23], s54 offen offset:2048 nt lds
    buffer_load_dwordx4 v5, s[20:23], s55 offen offset:3072 nt lds
    s_add_u32 m0, s44, 4096
    s_nop 0
    buffer_load_dwordx4 v2, s[24:27], s52 offen offset:0 nt lds
    buffer_load_dwordx4 v3, s[24:27], s53 offen offset:1024 nt lds
    buffer_load_dwordx4 v4, s[24:27], s54 offen offset:2048 nt lds
    buffer_load_dwordx4 v5, s[24:27], s55 offen offset:3072 nt lds
    s_add_u32 m0, s44, 8192
    s_nop 0
    buffer_load_dwordx4 v2, s[20:23], s64 offen offset:0 nt lds
    buffer_load_dwordx4 v3, s[20:23], s64 offen offset:1024 nt lds
    buffer_load_dwordx4 v4, s[20:23], s64 offen offset:2048 nt lds
    buffer_load_dwordx4 v5, s[20:23], s64 offen offset:3072 nt lds
    s_add_u32 m0, s44, 12288
    s_nop 0
    buffer_load_dwordx4 v2, s[24:27], s64 offen offset:0 nt lds
    buffer_load_dwordx4 v3, s[24:27], s64 offen offset:1024 nt lds
    buffer_load_dwordx4 v4, s[24:27], s64 offen offset:2048 nt lds
    buffer_load_dwordx4 v5, s[24:27], s64 offen offset:3072 nt lds
    s_waitcnt vmcnt(16)
    v_add_u32 v50, -1, v37
    v_cmp_lt_i32 vcc, 0, v37
    v_min_u32 v50, 0x7ff, v50
    v_lshrrev_b32 v24, 4, v50
    v_sub_u32 v24, v24, v46 clamp
    v_cndmask_b32 v22, 0, v22, vcc
    v_mov_b32 v49, v24
    v_add_u32_dpp v24, v24, v24 row_shr:1 row_mask:0xf bank_mask:0xf bound_ctrl:0
    v_add_u32 v47, v47, v49
    s_nop 0
    v_add_u32_dpp v24, v24, v24 row_shr:2 row_mask:0xf bank_mask:0xf bound_ctrl:0
    s_nop 1
    v_add_u32_dpp v24, v24, v24 row_shr:4 row_mask:0xf bank_mask:0xf bound_ctrl:0
    s_nop 1
    v_add_u32_dpp v24, v24, v24 row_shr:8 row_mask:0xf bank_mask:0xf bound_ctrl:0
    s_nop 1
    v_add_u32_dpp v24, v24, v24 row_bcast:15 row_mask:0xa bank_mask:0xf
    s_nop 0
    v_readlane_b32 s32, v24, 31
    v_add_u32 v25, 0x9e3779a0, v25
    v_and_b32 v25, 0xffffffe0, v25
    v_or_b32 v25, v25, v35
    v_sub_u32 v23, v24, v49
    s_max_u32 s31, s31, s32
    v_readlane_b32 s53, v24, s48
    v_readlane_b32 s52, v23, s48
    v_mul_u32_u24 v51, s31, v63
    v_lshrrev_b32 v51, 17, v51
    s_lshl_b32 s52, s52, 2
    s_lshl_b32 s53, s53, 2
    v_cmp_ge_u32 vcc, s52, v51
    v_cmp_gt_u32 s[54:55], s53, v51
    v_readlane_b32 s46, v25, s48
    v_readlane_b32 s63, v50, s48
    s_bcnt1_i32_b64 s3, vcc
    s_bcnt1_i32_b64 s65, s[54:55]
    s_sub_u32 s3, s3, 1
    s_sub_u32 s65, s65, s3
    s_cmp_eq_u32 s52, s53
    s_cselect_b32 s65, 0, s65
    s_add_u32 s62, s62, s3
    s_add_u32 s62, s62, s48
    s_lshl_b32 s3, s49, 5
    s_add_u32 s62, s62, s3
    s_lshl_b32 s62, s62, 12
    s_cmp_gt_u32 s65, 0
    s_cselect_b32 s6, s62, 0x40000000
    s_cselect_b32 s10, s46, 0
    s_cselect_b32 s96, 0, 0xf149f2ca
    s_add_u32 s62, s62, 4096
    s_cmp_gt_u32 s65, 1
    s_cselect_b32 s7, s62, 0x40000000
    s_cselect_b32 s11, s46, 0
    s_cselect_b32 s97, 0, 0xf149f2ca
    s_add_u32 s62, s62, 4096
    s_cmp_gt_u32 s65, 2
    s_cselect_b32 s8, s62, 0x40000000
    s_cselect_b32 s12, s46, 0
    s_cselect_b32 s98, 0, 0xf149f2ca
    s_add_u32 s62, s62, 4096
    s_cmp_gt_u32 s65, 3
    s_cselect_b32 s9, s62, 0x40000000
    s_cselect_b32 s13, s46, 0
    s_cselect_b32 s99, 0, 0xf149f2ca
    s_lshr_b32 s63, s63, 4
    s_add_u32 s63, s63, 1
    v_mov_b32 v24, s63
    s_lshl_b32 s3, s63, 2
    s_min_u32 s34, s34, s3
    s_add_u32 s63, s34, 3
    s_lshr_b32 s63, s63, 2
    s_min_u32 s37, s37, s63
    v_add_u32 v60, s37, v1
    s_mov_b32 s35, s48
    s_mov_b32 s36, s48
    s_sub_u32 s47, s63, 1
    s_lshl_b32 s3, s48, 2
    s_add_u32 s3, s3, s49
    s_lshl_b32 s3, s3, 11
    v_lshl_add_u32 v153, v0, 3, s3
    v_mov_b32 v62, 0x4010000
    s_branch L_COMMON
L_PPRO:
    s_mov_b32 s49, 0
    s_cmp_ge_u32 s50, 25
    s_addc_u32 s49, s49, 0
    s_cmp_ge_u32 s50, 74
    s_addc_u32 s49, s49, 0
    s_cmp_ge_u32 s50, 100
    s_addc_u32 s49, s49, 0
    v_lshlrev_b32 v36, 4, v1
    v_lshl_add_u32 v36, v34, 12, v36
    s_lshl_b32 s3, s28, 12
    s_add_u32 m0, s3, 65536
    v_lshrrev_b32 v40, 4, v1
    v_and_b32 v45, 7, v1
    v_and_b32 v41, 15, v1
    v_lshlrev_b32 v42, 1, v40
    v_xor_b32 v42, v41, v42
    v_xor_b32 v43, 8, v42
    v_lshlrev_b32 v44, 10, v40
    v_lshl_add_u32 v2, v42, 4, v44
    v_lshl_add_u32 v3, v43, 4, v44
    v_add_u32 v4, 6144, v2
    v_add_u32 v5, 9216, v3
    v_add_u32 v3, 3072, v3
    v_and_b32 v35, 31, v1
    v_lshlrev_b32 v38, 2, v35
    s_lshl_b32 s3, s49, 7
    s_add_u32 s3, s3, 0x3f0000
    v_add_u32 v156, s3, v38
    s_lshl_b32 s3, s49, 11
    v_lshl_add_u32 v155, v45, 8, s3
    v_lshl_add_u32 v155, v40, 4, v155
    s_lshl_b32 s44, s28, 14
    v_lshl_add_u32 v39, v1, 4, s44
    v_mov_b32 v112, 0
    v_mov_b32 v113, 0
    v_mov_b32 v114, 0
    v_mov_b32 v115, 0
    s_mov_b32 s22, 0x4010000
    s_mov_b32 s23, 0x00020000
    s_mov_b32 s26, 0x4010000
    s_mov_b32 s27, 0x00020000
    s_lshl_b32 s60, s49, 8
    s_waitcnt lgkmcnt(0)
    global_load_dword v37, v38, s[12:13]
    s_mov_b32 s20, s6
    s_and_b32 s21, s7, 0xffff
    s_mov_b32 s24, s8
    s_and_b32 s25, s9, 0xffff
    ds_write_b128 v39, v[112:115] offset:4096
    ds_write_b128 v39, v[112:115] offset:5120
    ds_write_b128 v39, v[112:115] offset:6144
    global_load_lds_dwordx4 v36, s[10:11] offset:0
    global_load_lds_dwordx4 v36, s[10:11] offset:1024
    global_load_lds_dwordx4 v36, s[10:11] offset:2048
    global_load_lds_dwordx4 v36, s[10:11] offset:3072
    s_mov_b32 s51, 0x6064736
    s_cmp_eq_u32 s49, 1
    s_cselect_b32 s51, 0x4043524, s51
    s_cmp_eq_u32 s49, 2
    s_cselect_b32 s51, 0x6064736, s51
    s_cmp_eq_u32 s49, 3
    s_cselect_b32 s51, 0x6064736, s51
    s_lshl_b32 s47, s49, 3
    s_lshr_b32 s46, 0x35372738, s47
    s_and_b32 s46, s46, 0xff
    v_lshlrev_b32 v43, 2, v1
    v_bfe_u32 v46, s51, v43, 4
    v_add3_u32 v46, v46, s46, -1
    v_lshl_add_u32 v47, v35, 7, v46
    v_add_u32 v47, 1, v47
    s_lshr_b32 s62, 0x644a1900, s47
    s_and_b32 s62, s62, 0xff
    s_lshr_b32 s3, 0x1c1a3119, s47
    s_and_b32 s3, s3, 0xff
    v_min_u32 v42, s3, v1
    v_add_lshl_u32 v43, v42, s62, 3
    s_mov_b32 s52, 0x88828480
    s_mov_b32 s53, 0x88848c88
    v_lshrrev_b64 v[52:53], v43, s[52:53]
    s_lshl_b32 s3, s62, 3
    s_lshr_b64 s[52:53], s[52:53], s3
    s_and_b32 s52, s52, 0xff
    v_and_b32 v52, 0xff, v52
    v_lshl_add_u32 v52, v42, 7, v52
    v_subrev_u32 v52, s52, v52
    s_lshl_b32 s3, s49, 4
    s_mov_b32 s52, 0x539fa3a3
    s_mov_b32 s53, 0x929d9d42
    s_lshr_b64 s[52:53], s[52:53], s3
    s_and_b32 s52, s52, 0xffff
    v_mul_u32_u24 v52, s52, v52
    v_lshrrev_b32 v63, 8, v52
    s_mov_b32 s52, 0x5d6026a
    s_mov_b32 s53, 0x2cf028c
    s_lshr_b64 s[52:53], s[52:53], s3
    s_and_b32 s31, s52, 0xffff
    v_mov_b32 v22, 0x3e0293ee
    global_load_dword v25, v156, s[18:19]
    s_sub_u32 s3, s50, s62
    v_readlane_b32 s96, v63, s3
    s_add_u32 s3, s3, 1
    v_readlane_b32 s97, v63, s3
    v_mov_b32 v62, 0x4010000
    s_sub_u32 s97, s97, s96
    s_mul_i32 s33, s97, s28
    s_add_u32 s34, s33, s97
    s_lshr_b32 s33, s33, 2
    s_lshr_b32 s34, s34, 2
    s_add_u32 s33, s33, s96
    s_add_u32 s34, s34, s96
    s_mov_b32 s46, 65536
    s_waitcnt vmcnt(5)
    v_add_u32 v50, -1, v37
    v_cmp_lt_i32 vcc, 0, v37
    v_min_u32 v50, 0x7ff, v50
    v_lshrrev_b32 v24, 4, v50
    v_sub_u32 v24, v24, v46 clamp
    v_cndmask_b32 v22, 0, v22, vcc
    v_mov_b32 v49, v24
    v_add_u32_dpp v24, v24, v24 row_shr:1 row_mask:0xf bank_mask:0xf bound_ctrl:0
    v_add_u32 v47, v47, v49
    s_nop 0
    v_add_u32_dpp v24, v24, v24 row_shr:2 row_mask:0xf bank_mask:0xf bound_ctrl:0
    s_nop 1
    v_add_u32_dpp v24, v24, v24 row_shr:4 row_mask:0xf bank_mask:0xf bound_ctrl:0
    s_nop 1
    v_add_u32_dpp v24, v24, v24 row_shr:8 row_mask:0xf bank_mask:0xf bound_ctrl:0
    s_nop 1
    v_add_u32_dpp v24, v24, v24 row_bcast:15 row_mask:0xa bank_mask:0xf
    s_nop 0
    v_readlane_b32 s32, v24, 31
    v_sub_u32 v47, v47, v24
    v_sub_u32 v23, v24, v49
    s_max_u32 s31, s31, s32
    s_mul_i32 s33, s33, s31
    s_lshr_b32 s37, s33, 19
    v_cmp_ge_u32 vcc, s37, v24
    s_mul_i32 s34, s34, s31
    v_add_u32 v60, s37, v1
    s_add_u32 s63, s34, 393216
    s_bcnt1_i32_b32 s35, vcc_lo
    s_lshr_b32 s63, s63, 19
    v_readlane_b32 s62, v47, s35
    s_min_u32 s63, s63, s32
    v_cmp_gt_u32 vcc, s63, v23
    s_cmp_ge_u32 s37, s32
    s_cbranch_scc1 L_EMPTY
    v_add_u32 v61, s62, v60
    s_bcnt1_i32_b32 s36, vcc_lo
    s_add_u32 s64, s35, 1
    s_cmp_ge_u32 s64, s36
    s_cbranch_scc1 L_TBL
L_TLOOP:
    v_readlane_b32 s3, v23, s64
    v_readlane_b32 s62, v47, s64
    s_add_u32 s64, s64, 1
    s_cmp_lt_u32 s64, s36
    v_cmp_le_u32 vcc, s3, v60
    v_add_u32 v59, s62, v60
    s_nop 0
    v_cndmask_b32 v61, v61, v59, vcc
    s_cbranch_scc1 L_TLOOP
L_TBL:
    v_and_b32 v61, 0xfff, v61
    v_lshl_add_u32 v61, v61, 2, s46
    s_waitcnt vmcnt(1)
    s_barrier
    ds_read_b32 v18, v61
    v_cmp_gt_u32 vcc, s63, v60
    s_mov_b32 m0, s44
    s_lshl_b32 s3, s35, 13
    v_add_u32 v58, s3, v155
    s_add_u32 s69, s35, 1
    s_min_u32 s3, s69, 31
    s_lshl_b32 s3, s3, 13
    v_add_u32 v59, s3, v155
    global_load_dwordx4 v[80:83], v58, s[4:5] offset:0
    global_load_dwordx4 v[84:87], v58, s[4:5] offset:64
    global_load_dwordx4 v[88:91], v58, s[4:5] offset:128
    global_load_dwordx4 v[92:95], v58, s[4:5] offset:192
    global_load_dwordx4 v[96:99], v59, s[4:5] offset:0
    global_load_dwordx4 v[100:103], v59, s[4:5] offset:64
    global_load_dwordx4 v[104:107], v59, s[4:5] offset:128
    global_load_dwordx4 v[108:111], v59, s[4:5] offset:192
    s_bfe_u32 s42, s33, 0x20011
    s_cmp_gt_u32 s42, 0
    s_cselect_b32 s52, 0x40000000, 0
    s_cmp_gt_u32 s42, 1
    s_cselect_b32 s53, 0x40000000, 0
    s_cmp_gt_u32 s42, 2
    s_cselect_b32 s54, 0x40000000, 0
    s_waitcnt lgkmcnt(0)
    v_lshl_add_u32 v18, v18, 14, s60
    v_cndmask_b32 v18, v62, v18, vcc
    s_nop 0
    v_readlane_b32 s55, v18, 0
    v_readlane_b32 s64, v18, 1
    s_or_b32 s52, s52, s55
    s_or_b32 s53, s53, s55
    s_or_b32 s54, s54, s55
    buffer_load_dwordx4 v2, s[20:23], s52 offen offset:0 nt lds
    buffer_load_dwordx4 v3, s[20:23], s53 offen offset:1024 nt lds
    buffer_load_dwordx4 v4, s[20:23], s54 offen offset:2048 nt lds
    buffer_load_dwordx4 v5, s[20:23], s55 offen offset:3072 nt lds
    s_add_u32 m0, s44, 4096
    s_nop 0
    buffer_load_dwordx4 v2, s[24:27], s52 offen offset:0 nt lds
    buffer_load_dwordx4 v3, s[24:27], s53 offen offset:1024 nt lds
    buffer_load_dwordx4 v4, s[24:27], s54 offen offset:2048 nt lds
    buffer_load_dwordx4 v5, s[24:27], s55 offen offset:3072 nt lds
    s_add_u32 m0, s44, 8192
    s_nop 0
    buffer_load_dwordx4 v2, s[20:23], s64 offen offset:0 nt lds
    buffer_load_dwordx4 v3, s[20:23], s64 offen offset:1024 nt lds
    buffer_load_dwordx4 v4, s[20:23], s64 offen offset:2048 nt lds
    buffer_load_dwordx4 v5, s[20:23], s64 offen offset:3072 nt lds
    s_add_u32 m0, s44, 12288
    s_nop 0
    buffer_load_dwordx4 v2, s[24:27], s64 offen offset:0 nt lds
    buffer_load_dwordx4 v3, s[24:27], s64 offen offset:1024 nt lds
    buffer_load_dwordx4 v4, s[24:27], s64 offen offset:2048 nt lds
    buffer_load_dwordx4 v5, s[24:27], s64 offen offset:3072 nt lds
    s_sub_u32 s36, s36, 1
    s_lshr_b32 s34, s34, 17
    s_lshl_b32 s3, s32, 2
    s_min_u32 s34, s34, s3
    s_mov_b32 s98, 0
    s_mul_i32 s52, s96, s31
    s_lshr_b32 s3, s52, 19
    v_cmp_ge_u32 vcc, s3, v24
    s_mul_i32 s52, s97, 1
    s_lshr_b32 s52, s52, 2
    s_add_u32 s52, s52, s96
    s_mul_i32 s52, s52, s31
    s_bcnt1_i32_b32 s6, vcc_lo
    s_add_u32 s3, s52, 393216
    s_lshr_b32 s3, s3, 19
    s_min_u32 s3, s3, s32
    v_cmp_gt_u32 vcc, s3, v23
    s_bcnt1_i32_b32 s10, vcc_lo
    s_sub_u32 s10, s10, 1
    s_min_u32 s6, s6, s10
    s_bitset1_b32 s98, s6
    s_bitset1_b32 s98, s10
    s_lshr_b32 s3, s52, 19
    v_cmp_ge_u32 vcc, s3, v24
    s_mul_i32 s52, s97, 2
    s_lshr_b32 s52, s52, 2
    s_add_u32 s52, s52, s96
    s_mul_i32 s52, s52, s31
    s_bcnt1_i32_b32 s7, vcc_lo
    s_add_u32 s3, s52, 393216
    s_lshr_b32 s3, s3, 19
    s_min_u32 s3, s3, s32
    v_cmp_gt_u32 vcc, s3, v23
    s_bcnt1_i32_b32 s11, vcc_lo
    s_sub_u32 s11, s11, 1
    s_min_u32 s7, s7, s11
    s_bitset1_b32 s98, s7
    s_bitset1_b32 s98, s11
    s_lshr_b32 s3, s52, 19
    v_cmp_ge_u32 vcc, s3, v24
    s_mul_i32 s52, s97, 3
    s_lshr_b32 s52, s52, 2
    s_add_u32 s52, s52, s96
    s_mul_i32 s52, s52, s31
    s_bcnt1_i32_b32 s8, vcc_lo
    s_add_u32 s3, s52, 393216
    s_lshr_b32 s3, s3, 19
    s_min_u32 s3, s3, s32
    v_cmp_gt_u32 vcc, s3, v23
    s_bcnt1_i32_b32 s12, vcc_lo
    s_sub_u32 s12, s12, 1
    s_min_u32 s8, s8, s12
    s_bitset1_b32 s98, s8
    s_bitset1_b32 s98, s12
    s_lshr_b32 s3, s52, 19
    v_cmp_ge_u32 vcc, s3, v24
    s_mul_i32 s52, s97, 4
    s_lshr_b32 s52, s52, 2
    s_add_u32 s52, s52, s96
    s_mul_i32 s52, s52, s31
    s_bcnt1_i32_b32 s9, vcc_lo
    s_add_u32 s3, s52, 393216
    s_lshr_b32 s3, s3, 19
    s_min_u32 s3, s3, s32
    v_cmp_gt_u32 vcc, s3, v23
    s_bcnt1_i32_b32 s13, vcc_lo
    s_sub_u32 s13, s13, 1
    s_min_u32 s9, s9, s13
    s_bitset1_b32 s98, s9
    s_bitset1_b32 s98, s13
    s_lshl_b32 s99, s49, 5
    s_add_u32 s99, s99, s50
    s_mov_b32 s47, -1
    v_mov_b32 v153, 0
    s_waitcnt vmcnt(24)
    v_add_u32 v25, 0x9e3779a0, v25
    v_and_b32 v25, 0xffffffe0, v25
    v_or_b32 v25, v25, v35
L_COMMON:
    v_lshlrev_b32 v42, 1, v45
    v_xor_b32 v42, v40, v42
    v_lshl_add_u32 v43, v41, 8, s44
    v_lshl_add_u32 v6, v42, 4, v43
    v_xor_b32 v7, 64, v6
    v_xor_b32 v8, 0x80, v6
    v_xor_b32 v9, 0xc0, v6
    v_lshrrev_b32 v42, 2, v1
    v_and_b32 v43, 7, v42
    v_lshlrev_b32 v43, 5, v43
    v_and_b32 v44, 3, v1
    v_lshlrev_b32 v44, 3, v44
    v_or_b32 v43, v43, v44
    v_lshl_add_u32 v42, v42, 8, s44
    v_add_u32 v10, v42, v43
    v_xor_b32 v11, 32, v10
    v_xor_b32 v12, 64, v10
    v_xor_b32 v13, 96, v10
    v_xor_b32 v14, 128, v10
    v_xor_b32 v15, 160, v10
    v_xor_b32 v16, 192, v10
    v_xor_b32 v17, 224, v10
    v_lshlrev_b32 v154, 2, v40
    s_mov_b32 s66, 0x00ff00ff
    s_mov_b32 s67, 0x00ff00ff
    s_mov_b32 s45, 0
    s_mov_b32 s30, 4
    s_mov_b32 s56, s18
    s_and_b32 s57, s19, 0xffff
    s_mov_b32 s58, 0x400000
    s_mov_b32 s59, 0x00020000
    v_min_u32 v20, s63, v24
    v_add_u32 v59, 1, v60
    v_and_b32 v50, 15, v50
    v_mov_b32 v21, 15
    s_mov_b32 s64, s36
L_LV:
    v_readlane_b32 s3, v24, s64
    v_readlane_b32 s62, v50, s64
    s_cmp_gt_u32 s64, s35
    s_cselect_b32 s65, 1, 0
    v_cmp_eq_u32 vcc, s3, v59
    v_mov_b32 v34, s62
    s_sub_u32 s64, s64, s65
    v_cndmask_b32 v21, v21, v34, vcc
    s_cmp_lg_u32 s65, 0
    s_cbranch_scc1 L_LV
    s_sub_u32 s3, s34, 1
    s_and_b32 s3, s3, 3
    s_lshl_b32 s65, s3, 2
    s_add_u32 s65, s65, 3
    v_cmp_eq_u32 vcc, s63, v59
    v_min_u32 v34, s65, v21
    s_mov_b32 s43, s37
    v_cndmask_b32 v21, v21, v34, vcc
    v_cmp_gt_u32 s[88:89], 4, v21
    v_cmp_gt_u32 s[90:91], 8, v21
    v_cmp_gt_u32 s[92:93], 12, v21
    s_lshl_b32 s42, s42, 2
    s_sub_u32 s32, s63, s37
    v_cndmask_b32 v158, v18, v62, s[88:89]
    v_cndmask_b32 v159, v18, v62, s[90:91]
    v_cndmask_b32 v160, v18, v62, s[92:93]
    s_lshl_b32 s32, s32, 1
    v_readlane_b32 s84, v18, 2
    v_readlane_b32 s85, v158, 2
    v_readlane_b32 s86, v159, 2
    v_readlane_b32 s87, v160, 2
    s_mov_b32 s33, 16
    v_bfe_u32 v42, v1, 3, 1
    s_mov_b32 s61, -1
    v_lshlrev_b32 v151, 9, v45
    v_lshl_add_u32 v151, v42, 8, v151
    v_lshl_add_u32 v151, v40, 4, v151
    v_mul_u32_u24 v148, 528, v45
    v_lshl_add_u32 v148, v42, 8, v148
    v_lshl_add_u32 v148, v40, 4, v148
    v_add_u32 v148, s44, v148
    v_lshrrev_b32 v42, 5, v0
    v_mul_u32_u24 v42, 528, v42
    v_add_u32 v149, 512, v42
    v_lshl_add_u32 v150, v35, 4, v42
    v_lshlrev_b32 v152, 4, v0
    v_mov_b32 v38, 0xf149f2ca
    v_mov_b32 v40, 0
    v_mov_b32 v44, 0x3f803f80
    v_mov_b32 v41, 0
    v_mov_b32 v45, 0x3f803f80
    v_mov_b32 v42, 0
    v_mov_b32 v46, 0x3f803f80
    v_mov_b32 v43, 0
    v_mov_b32 v47, 0x3f803f80
L_SEG:
    v_readlane_b32 s38, v20, s35
    v_readlane_b32 s41, v22, s35
    v_mov_b32 v26, 0xf149f2ca
    v_mov_b32 v112, 0
    v_mov_b32 v113, 0
    v_mov_b32 v114, 0
    v_mov_b32 v115, 0
    v_mov_b32 v116, 0
    v_mov_b32 v117, 0
    v_mov_b32 v118, 0
    v_mov_b32 v119, 0
    v_mov_b32 v120, 0
    v_mov_b32 v121, 0
    v_mov_b32 v122, 0
    v_mov_b32 v123, 0
    v_mov_b32 v124, 0
    v_mov_b32 v125, 0
    v_mov_b32 v126, 0
    v_mov_b32 v127, 0
    v_mov_b32 v128, 0
    v_mov_b32 v129, 0
    v_mov_b32 v130, 0
    v_mov_b32 v131, 0
    s_sub_u32 s39, s38, 1
    s_sub_u32 s3, s39, s43
    v_readlane_b32 s40, v21, s3
    s_cmp_eq_u32 s38, s37
    s_cbranch_scc1 L_NOPG
L_LOOP:
    s_cmp_eq_u32 s37, s47
    s_cbranch_scc1 L_PISSUE
L_PD:
    s_sub_u32 s33, s33, 4
    s_waitcnt vmcnt(12)
    s_cmp_ge_u32 s33, 12
    s_cbranch_scc1 L_KD
    s_waitcnt vmcnt(8)
    s_cmp_ge_u32 s33, 8
    s_cbranch_scc1 L_KD
    s_waitcnt vmcnt(4)
L_KD:
    ds_read_b128 v[48:51], v6
    ds_read_b128 v[52:55], v7
    ds_read_b128 v[56:59], v8
    ds_read_b128 v[60:63], v9
    s_waitcnt lgkmcnt(3)
    v_mfma_f32_16x16x32_bf16 v[28:31], v[48:51], v[80:83], 0
    s_waitcnt lgkmcnt(2)
    v_mfma_f32_16x16x32_bf16 v[28:31], v[52:55], v[84:87], v[28:31]
    s_waitcnt lgkmcnt(1)
    v_mfma_f32_16x16x32_bf16 v[28:31], v[56:59], v[88:91], v[28:31]
    s_waitcnt lgkmcnt(0)
    v_mfma_f32_16x16x32_bf16 v[28:31], v[60:63], v[92:95], v[28:31]
L_IA:
    s_cmp_ge_u32 s30, s32
    s_cbranch_scc1 L_IAD
    s_and_b32 s3, s30, 3
    s_lshl_b32 s3, s3, 12
    s_add_u32 m0, s44, s3
    s_add_u32 s33, s33, 4
    s_add_u32 s30, s30, 1
    buffer_load_dwordx4 v2, s[20:23], s84 offen offset:0 nt lds
    buffer_load_dwordx4 v3, s[20:23], s85 offen offset:1024 nt lds
    buffer_load_dwordx4 v4, s[20:23], s86 offen offset:2048 nt lds
    buffer_load_dwordx4 v5, s[20:23], s87 offen offset:3072 nt lds
L_IAD:
    v_xor_b32 v6, 0x2000, v6
    v_xor_b32 v7, 0x2000, v7
    v_xor_b32 v8, 0x2000, v8
    v_xor_b32 v9, 0x2000, v9
    s_cmp_eq_u32 s37, s39
    s_cbranch_scc1 L_MASK
    s_cmp_eq_u32 s37, s43
    s_cbranch_scc1 L_MASK
L_MASKD:
    v_max_f32 v34, v28, v29
    v_max3_f32 v34, v30, v31, v34
    v_mov_b32 v35, v34
    s_nop 1
    v_permlane32_swap_b32 v34, v35
    v_max_f32 v34, v34, v35
    v_mov_b32 v35, v34
    s_nop 1
    v_permlane16_swap_b32 v34, v35
    v_max_f32 v34, v34, v35
    v_mul_f32 v34, s41, v34
    v_max_f32 v35, v26, v34
    v_sub_f32 v36, v26, v35
    v_fma_f32 v28, v28, s41, -v35
    v_fma_f32 v29, v29, s41, -v35
    v_fma_f32 v30, v30, s41, -v35
    v_fma_f32 v31, v31, s41, -v35
    s_cbranch_scc1 L_MASK2
L_MASK2D:
    v_exp_f32 v36, v36
    v_exp_f32 v28, v28
    v_exp_f32 v29, v29
    v_exp_f32 v30, v30
    v_exp_f32 v31, v31
    v_mov_b32 v26, v35
    v_mul_f32 v128, v128, v36
    s_mov_b64 exec, s[66:67]
    v_cvt_pk_bf16_f32 v40, v28, v29
    v_cvt_pk_bf16_f32 v41, v30, v31
    s_not_b64 exec, exec
    v_cvt_pk_bf16_f32 v42, v28, v29
    v_cvt_pk_bf16_f32 v43, v30, v31
    s_mov_b64 exec, -1
    v_pk_mul_f32 v[112:113], v[112:113], v[36:37] op_sel_hi:[1,0]
    v_pk_mul_f32 v[114:115], v[114:115], v[36:37] op_sel_hi:[1,0]
    v_pk_mul_f32 v[116:117], v[116:117], v[36:37] op_sel_hi:[1,0]
    v_pk_mul_f32 v[118:119], v[118:119], v[36:37] op_sel_hi:[1,0]
    v_pk_mul_f32 v[120:121], v[120:121], v[36:37] op_sel_hi:[1,0]
    v_pk_mul_f32 v[122:123], v[122:123], v[36:37] op_sel_hi:[1,0]
    v_pk_mul_f32 v[124:125], v[124:125], v[36:37] op_sel_hi:[1,0]
    v_pk_mul_f32 v[126:127], v[126:127], v[36:37] op_sel_hi:[1,0]
    v_mfma_f32_16x16x32_bf16 v[128:131], v[44:47], v[40:43], v[128:131]
    s_sub_u32 s33, s33, 4
    s_waitcnt vmcnt(12)
    s_cmp_ge_u32 s33, 12
    s_cbranch_scc1 L_VD
    s_waitcnt vmcnt(8)
    s_cmp_ge_u32 s33, 8
    s_cbranch_scc1 L_VD
    s_waitcnt vmcnt(4)
    s_cmp_ge_u32 s33, 4
    s_cbranch_scc1 L_VD
    s_waitcnt vmcnt(0)
L_VD:
    ds_read_b64_tr_b16 v[64:65], v10 offset:4096
    ds_read_b64_tr_b16 v[66:67], v14 offset:4096
    ds_read_b64_tr_b16 v[68:69], v11 offset:4096
    ds_read_b64_tr_b16 v[70:71], v15 offset:4096
    ds_read_b64_tr_b16 v[72:73], v12 offset:4096
    ds_read_b64_tr_b16 v[74:75], v16 offset:4096
    ds_read_b64_tr_b16 v[76:77], v13 offset:4096
    ds_read_b64_tr_b16 v[78:79], v17 offset:4096
    v_xor_b32 v10, 0x2000, v10
    v_xor_b32 v11, 0x2000, v11
    v_xor_b32 v12, 0x2000, v12
    v_xor_b32 v13, 0x2000, v13
    v_xor_b32 v14, 0x2000, v14
    v_xor_b32 v15, 0x2000, v15
    v_xor_b32 v16, 0x2000, v16
    v_xor_b32 v17, 0x2000, v17
    s_waitcnt lgkmcnt(6)
    v_mfma_f32_16x16x32_bf16 v[112:115], v[64:67], v[40:43], v[112:115]
    s_waitcnt lgkmcnt(4)
    v_mfma_f32_16x16x32_bf16 v[116:119], v[68:71], v[40:43], v[116:119]
    s_waitcnt lgkmcnt(2)
    v_mfma_f32_16x16x32_bf16 v[120:123], v[72:75], v[40:43], v[120:123]
    s_waitcnt lgkmcnt(0)
    v_mfma_f32_16x16x32_bf16 v[124:127], v[76:79], v[40:43], v[124:127]
L_IB:
    s_cmp_ge_u32 s30, s32
    s_cbranch_scc1 L_IBD
    s_and_b32 s3, s30, 3
    s_lshl_b32 s3, s3, 12
    s_add_u32 m0, s44, s3
    s_add_u32 s33, s33, 4
    s_add_u32 s30, s30, 1
    buffer_load_dwordx4 v2, s[24:27], s84 offen offset:0 nt lds
    buffer_load_dwordx4 v3, s[24:27], s85 offen offset:1024 nt lds
    buffer_load_dwordx4 v4, s[24:27], s86 offen offset:2048 nt lds
    buffer_load_dwordx4 v5, s[24:27], s87 offen offset:3072 nt lds
    s_lshr_b32 s3, s30, 1
    v_readlane_b32 s84, v18, s3
    v_readlane_b32 s85, v158, s3
    v_readlane_b32 s86, v159, s3
    v_readlane_b32 s87, v160, s3
L_IBD:
    s_add_u32 s37, s37, 1
    s_cmp_lt_u32 s37, s38
    s_cbranch_scc1 L_LOOP
L_FLUSH:
    s_cmp_eq_u32 s35, s36
    s_cbranch_scc0 L_MID
    s_mov_b64 exec, 0xff
    ds_write2_b32 v148, v26, v128 offset0:128 offset1:129
    s_mov_b64 exec, -1
    ds_write_b128 v148, v[112:115] offset:0
    ds_write_b128 v148, v[116:119] offset:64
    ds_write_b128 v148, v[120:123] offset:128
    ds_write_b128 v148, v[124:127] offset:192
    s_bitcmp1_b32 s2, 3
    s_cbranch_scc1 L_PEND
    s_waitcnt vmcnt(0)
    v_xor_b32 v32, s10, v135
    v_xor_b32 v33, s11, v139
    v_xor_b32 v34, s12, v143
    v_xor_b32 v35, s13, v147
    v_or3_b32 v32, v32, v33, v34
    v_or_b32 v32, v32, v35
    v_cmp_ne_u32 vcc, 0, v32
    v_lshlrev_b32 v80, 16, v132
    v_and_b32 v81, 0xffff0000, v132
    v_lshlrev_b32 v82, 16, v133
    v_and_b32 v83, 0xffff0000, v133
    v_lshlrev_b32 v84, 16, v136
    v_and_b32 v85, 0xffff0000, v136
    v_lshlrev_b32 v86, 16, v137
    v_and_b32 v87, 0xffff0000, v137
    v_lshlrev_b32 v88, 16, v140
    v_and_b32 v89, 0xffff0000, v140
    v_lshlrev_b32 v90, 16, v141
    v_and_b32 v91, 0xffff0000, v141
    v_lshlrev_b32 v92, 16, v144
    v_and_b32 v93, 0xffff0000, v144
    v_lshlrev_b32 v94, 16, v145
    v_and_b32 v95, 0xffff0000, v145
    s_cbranch_vccnz L_RP1
L_RP1D:
    s_waitcnt lgkmcnt(0)
    s_barrier
    ds_read2st64_b64 v[48:51], v149 offset0:0 offset1:32
    ds_read2st64_b64 v[52:55], v149 offset0:64 offset1:96
    ds_read_b128 v[56:59], v150 offset:0
    ds_read_b128 v[60:63], v150 offset:16384
    ds_read_b128 v[64:67], v150 offset:32768
    ds_read_b128 v[68:71], v150 offset:49152
    s_cbranch_vccnz L_RETRY
L_FOLD:
    v_add_f32 v72, s96, v134
    v_add_f32 v74, s97, v138
    v_add_f32 v76, s98, v142
    v_add_f32 v78, s99, v146
    v_max3_f32 v36, v72, v74, v76
    v_max_f32 v36, v36, v78
    v_sub_f32 v72, v72, v36
    v_sub_f32 v74, v74, v36
    v_sub_f32 v76, v76, v36
    v_sub_f32 v78, v78, v36
    v_exp_f32 v72, v72
    v_exp_f32 v74, v74
    v_exp_f32 v76, v76
    v_exp_f32 v78, v78
    v_pk_mul_f32 v[28:29], v[80:81], v[72:73] op_sel_hi:[1,0]
    v_pk_mul_f32 v[30:31], v[82:83], v[72:73] op_sel_hi:[1,0]
    v_pk_fma_f32 v[28:29], v[84:85], v[74:75], v[28:29] op_sel_hi:[1,0,1]
    v_pk_fma_f32 v[30:31], v[86:87], v[74:75], v[30:31] op_sel_hi:[1,0,1]
    v_pk_fma_f32 v[28:29], v[88:89], v[76:77], v[28:29] op_sel_hi:[1,0,1]
    v_pk_fma_f32 v[30:31], v[90:91], v[76:77], v[30:31] op_sel_hi:[1,0,1]
    v_pk_fma_f32 v[28:29], v[92:93], v[78:79], v[28:29] op_sel_hi:[1,0,1]
    v_pk_fma_f32 v[30:31], v[94:95], v[78:79], v[30:31] op_sel_hi:[1,0,1]
    v_add_f32 v37, v72, v74
    v_add_f32 v34, v76, v78
    v_add_f32 v37, v37, v34
    s_waitcnt lgkmcnt(4)
    v_max3_f32 v34, v48, v50, v36
    v_max3_f32 v34, v52, v54, v34
    v_sub_f32 v36, v36, v34
    v_sub_f32 v48, v48, v34
    v_sub_f32 v50, v50, v34
    v_sub_f32 v52, v52, v34
    v_sub_f32 v54, v54, v34
    v_exp_f32 v36, v36
    v_exp_f32 v48, v48
    v_exp_f32 v50, v50
    v_exp_f32 v52, v52
    v_exp_f32 v54, v54
    v_mul_f32 v38, v36, v37
    v_fma_f32 v38, v48, v49, v38
    v_fma_f32 v38, v50, v51, v38
    v_fma_f32 v38, v52, v53, v38
    v_fma_f32 v38, v54, v55, v38
    v_pk_mul_f32 v[28:29], v[28:29], v[36:37] op_sel_hi:[1,0]
    v_pk_mul_f32 v[30:31], v[30:31], v[36:37] op_sel_hi:[1,0]
    v_rcp_f32 v38, v38
    s_waitcnt lgkmcnt(3)
    v_pk_fma_f32 v[28:29], v[56:57], v[48:49], v[28:29] op_sel_hi:[1,0,1]
    v_pk_fma_f32 v[30:31], v[58:59], v[48:49], v[30:31] op_sel_hi:[1,0,1]
    s_waitcnt lgkmcnt(2)
    v_pk_fma_f32 v[28:29], v[60:61], v[50:51], v[28:29] op_sel_hi:[1,0,1]
    v_pk_fma_f32 v[30:31], v[62:63], v[50:51], v[30:31] op_sel_hi:[1,0,1]
    s_waitcnt lgkmcnt(1)
    v_pk_fma_f32 v[28:29], v[64:65], v[52:53], v[28:29] op_sel_hi:[1,0,1]
    v_pk_fma_f32 v[30:31], v[66:67], v[52:53], v[30:31] op_sel_hi:[1,0,1]
    s_waitcnt lgkmcnt(0)
    v_pk_fma_f32 v[28:29], v[68:69], v[54:55], v[28:29] op_sel_hi:[1,0,1]
    v_pk_fma_f32 v[30:31], v[70:71], v[54:55], v[30:31] op_sel_hi:[1,0,1]
    v_pk_mul_f32 v[28:29], v[28:29], v[38:39] op_sel_hi:[1,0]
    v_pk_mul_f32 v[30:31], v[30:31], v[38:39] op_sel_hi:[1,0]
    v_cvt_pk_bf16_f32 v32, v28, v29
    v_cvt_pk_bf16_f32 v33, v30, v31
    global_store_dwordx2 v153, v[32:33], s[14:15]
    s_cmp_lg_u32 s28, 0
    s_cbranch_scc1 L_EXIT
    s_lshl_b64 exec, 1, s48
    global_store_dword v156, v25, s[18:19] sc1
    s_branch L_EXIT
L_RP1:
    buffer_load_dwordx4 v[132:135], v152, s[56:59], s6 offen sc1
    buffer_load_dwordx4 v[136:139], v152, s[56:59], s7 offen sc1
    buffer_load_dwordx4 v[140:143], v152, s[56:59], s8 offen sc1
    buffer_load_dwordx4 v[144:147], v152, s[56:59], s9 offen sc1
    s_branch L_RP1D
L_REPOLL:
    buffer_load_dwordx4 v[132:135], v152, s[56:59], s6 offen sc1
    buffer_load_dwordx4 v[136:139], v152, s[56:59], s7 offen sc1
    buffer_load_dwordx4 v[140:143], v152, s[56:59], s8 offen sc1
    buffer_load_dwordx4 v[144:147], v152, s[56:59], s9 offen sc1
L_RETRY:
    s_waitcnt vmcnt(0)
    v_xor_b32 v32, s10, v135
    v_xor_b32 v33, s11, v139
    v_xor_b32 v34, s12, v143
    v_xor_b32 v35, s13, v147
    v_or3_b32 v32, v32, v33, v34
    v_or_b32 v32, v32, v35
    v_cmp_ne_u32 vcc, 0, v32
    s_add_u32 s45, s45, 1
    s_cmp_ge_u32 s45, 65536
    s_cbranch_scc1 L_GOT
    s_cbranch_vccnz L_REPOLL
L_GOT:
    v_lshlrev_b32 v80, 16, v132
    v_and_b32 v81, 0xffff0000, v132
    v_lshlrev_b32 v82, 16, v133
    v_and_b32 v83, 0xffff0000, v133
    v_lshlrev_b32 v84, 16, v136
    v_and_b32 v85, 0xffff0000, v136
    v_lshlrev_b32 v86, 16, v137
    v_and_b32 v87, 0xffff0000, v137
    v_lshlrev_b32 v88, 16, v140
    v_and_b32 v89, 0xffff0000, v140
    v_lshlrev_b32 v90, 16, v141
    v_and_b32 v91, 0xffff0000, v141
    v_lshlrev_b32 v92, 16, v144
    v_and_b32 v93, 0xffff0000, v144
    v_lshlrev_b32 v94, 16, v145
    v_and_b32 v95, 0xffff0000, v145
    s_branch L_FOLD
L_PEND:
    s_cmp_eq_u32 s61, -1
    s_cbranch_scc1 L_PBAR
    buffer_store_dwordx4 v[132:135], v151, s[56:59], s61 offen offset:0 sc1
    buffer_store_dwordx4 v[136:139], v151, s[56:59], s61 offen offset:64 sc1
    buffer_store_dwordx4 v[140:143], v151, s[56:59], s61 offen offset:128 sc1
    buffer_store_dwordx4 v[144:147], v151, s[56:59], s61 offen offset:192 sc1
L_PBAR:
    s_waitcnt lgkmcnt(0)
    s_barrier
L_PM:
    s_ff1_i32_b32 s35, s98
    s_bitset0_b32 s98, s35
    s_cmp_eq_u32 s6, s35
    s_cselect_b32 s88, 81920, 0
    s_cselect_b32 s92, 0, 0xf149f2ca
    s_cmp_eq_u32 s10, s35
    s_cselect_b32 s88, 0, s88
    s_cselect_b32 s92, 0, s92
    v_add_u32 v72, s88, v149
    ds_read_b64 v[48:49], v72 offset:0
    s_cmp_eq_u32 s7, s35
    s_cselect_b32 s89, 69760, 0
    s_cselect_b32 s93, 0, 0xf149f2ca
    s_cmp_eq_u32 s11, s35
    s_cselect_b32 s89, 0, s89
    s_cselect_b32 s93, 0, s93
    v_add_u32 v73, s89, v149
    ds_read_b64 v[50:51], v73 offset:16384
    s_cmp_eq_u32 s8, s35
    s_cselect_b32 s90, 57600, 0
    s_cselect_b32 s94, 0, 0xf149f2ca
    s_cmp_eq_u32 s12, s35
    s_cselect_b32 s90, 0, s90
    s_cselect_b32 s94, 0, s94
    v_add_u32 v74, s90, v149
    ds_read_b64 v[52:53], v74 offset:32768
    s_cmp_eq_u32 s9, s35
    s_cselect_b32 s91, 45440, 0
    s_cselect_b32 s95, 0, 0xf149f2ca
    s_cmp_eq_u32 s13, s35
    s_cselect_b32 s91, 0, s91
    s_cselect_b32 s95, 0, s95
    v_add_u32 v75, s91, v149
    ds_read_b64 v[54:55], v75 offset:49152
    v_add_u32 v76, s88, v150
    ds_read_b128 v[56:59], v76 offset:0
    v_add_u32 v77, s89, v150
    ds_read_b128 v[60:63], v77 offset:16384
    v_add_u32 v78, s90, v150
    ds_read_b128 v[64:67], v78 offset:32768
    v_add_u32 v79, s91, v150
    ds_read_b128 v[68:71], v79 offset:49152
    v_readlane_b32 s46, v25, s35
    s_add_u32 s68, s99, s35
    s_lshl_b32 s68, s68, 12
    s_waitcnt lgkmcnt(4)
    v_add_f32 v48, s92, v48
    v_add_f32 v50, s93, v50
    v_add_f32 v52, s94, v52
    v_add_f32 v54, s95, v54
    v_max_f32 v34, v48, v50
    v_max3_f32 v34, v52, v54, v34
    v_sub_f32 v48, v48, v34
    v_sub_f32 v50, v50, v34
    v_sub_f32 v52, v52, v34
    v_sub_f32 v54, v54, v34
    v_exp_f32 v48, v48
    v_exp_f32 v50, v50
    v_exp_f32 v52, v52
    v_exp_f32 v54, v54
    v_mov_b32 v35, s46
    v_mul_f32 v36, v48, v49
    v_fma_f32 v36, v50, v51, v36
    v_fma_f32 v36, v52, v53, v36
    v_fma_f32 v36, v54, v55, v36
    v_max_f32 v36, 0xda24260, v36
    v_rcp_f32 v38, v36
    v_log_f32 v36, v36
    s_waitcnt lgkmcnt(3)
    v_pk_mul_f32 v[28:29], v[56:57], v[48:49] op_sel_hi:[1,0]
    v_pk_mul_f32 v[30:31], v[58:59], v[48:49] op_sel_hi:[1,0]
    s_waitcnt lgkmcnt(2)
    v_pk_fma_f32 v[28:29], v[60:61], v[50:51], v[28:29] op_sel_hi:[1,0,1]
    v_pk_fma_f32 v[30:31], v[62:63], v[50:51], v[30:31] op_sel_hi:[1,0,1]
    s_waitcnt lgkmcnt(1)
    v_pk_fma_f32 v[28:29], v[64:65], v[52:53], v[28:29] op_sel_hi:[1,0,1]
    v_pk_fma_f32 v[30:31], v[66:67], v[52:53], v[30:31] op_sel_hi:[1,0,1]
    s_waitcnt lgkmcnt(0)
    v_pk_fma_f32 v[28:29], v[68:69], v[54:55], v[28:29] op_sel_hi:[1,0,1]
    v_pk_fma_f32 v[30:31], v[70:71], v[54:55], v[30:31] op_sel_hi:[1,0,1]
    v_pk_mul_f32 v[28:29], v[28:29], v[38:39] op_sel_hi:[1,0]
    v_pk_mul_f32 v[30:31], v[30:31], v[38:39] op_sel_hi:[1,0]
    v_cvt_pk_bf16_f32 v32, v28, v29
    v_cvt_pk_bf16_f32 v33, v30, v31
    v_add_f32 v34, v34, v36
    buffer_store_dwordx4 v[32:35], v152, s[56:59], s68 offen sc1
    s_cmp_lg_u32 s98, 0
    s_cbranch_scc1 L_PM
    s_branch L_EXIT
L_MID:
    s_add_u32 s3, s35, 1
    s_cmp_eq_u32 s3, s69
    s_cbranch_scc0 L_INNER
    s_mul_i32 s3, s28, -12160
    s_add_u32 s3, s3, 81920
    v_add_u32 v34, s3, v148
    s_mov_b64 exec, 0xff
    ds_write2_b32 v34, v26, v128 offset0:128 offset1:129
    s_mov_b64 exec, -1
    ds_write_b128 v34, v[112:115] offset:0
    ds_write_b128 v34, v[116:119] offset:64
    ds_write_b128 v34, v[120:123] offset:128
    ds_write_b128 v34, v[124:127] offset:192
L_NEXT:
    s_add_u32 s35, s35, 1
    s_cmp_eq_u32 s35, s69
    s_cbranch_scc0 L_QLOAD
    v_mov_b32 v80, v96
    v_mov_b32 v81, v97
    v_mov_b32 v82, v98
    v_mov_b32 v83, v99
    v_mov_b32 v84, v100
    v_mov_b32 v85, v101
    v_mov_b32 v86, v102
    v_mov_b32 v87, v103
    v_mov_b32 v88, v104
    v_mov_b32 v89, v105
    v_mov_b32 v90, v106
    v_mov_b32 v91, v107
    v_mov_b32 v92, v108
    v_mov_b32 v93, v109
    v_mov_b32 v94, v110
    v_mov_b32 v95, v111
    s_branch L_SEG
L_QLOAD:
    s_lshl_b32 s3, s35, 13
    v_add_u32 v34, s3, v155
    global_load_dwordx4 v[80:83], v34, s[4:5] offset:0
    global_load_dwordx4 v[84:87], v34, s[4:5] offset:64
    global_load_dwordx4 v[88:91], v34, s[4:5] offset:128
    global_load_dwordx4 v[92:95], v34, s[4:5] offset:192
    s_waitcnt vmcnt(0)
    s_branch L_SEG
L_INNER:
    s_cmp_eq_u32 s61, -1
    s_cbranch_scc1 L_HOLD
    buffer_store_dwordx4 v[132:135], v151, s[56:59], s61 offen offset:0 sc1
    buffer_store_dwordx4 v[136:139], v151, s[56:59], s61 offen offset:64 sc1
    buffer_store_dwordx4 v[140:143], v151, s[56:59], s61 offen offset:128 sc1
    buffer_store_dwordx4 v[144:147], v151, s[56:59], s61 offen offset:192 sc1
L_HOLD:
    v_readlane_b32 s46, v25, s35
    v_max_f32 v34, 0xda24260, v128
    v_rcp_f32 v36, v34
    v_log_f32 v34, v34
    s_add_u32 s61, s99, s35
    s_lshl_b32 s61, s61, 12
    v_pk_mul_f32 v[112:113], v[112:113], v[36:37] op_sel_hi:[1,0]
    v_pk_mul_f32 v[114:115], v[114:115], v[36:37] op_sel_hi:[1,0]
    v_pk_mul_f32 v[116:117], v[116:117], v[36:37] op_sel_hi:[1,0]
    v_pk_mul_f32 v[118:119], v[118:119], v[36:37] op_sel_hi:[1,0]
    v_pk_mul_f32 v[120:121], v[120:121], v[36:37] op_sel_hi:[1,0]
    v_pk_mul_f32 v[122:123], v[122:123], v[36:37] op_sel_hi:[1,0]
    v_pk_mul_f32 v[124:125], v[124:125], v[36:37] op_sel_hi:[1,0]
    v_pk_mul_f32 v[126:127], v[126:127], v[36:37] op_sel_hi:[1,0]
    v_cvt_pk_bf16_f32 v132, v112, v113
    v_cvt_pk_bf16_f32 v133, v114, v115
    v_add_f32 v134, v26, v34
    v_mov_b32 v135, s46
    v_cvt_pk_bf16_f32 v136, v116, v117
    v_cvt_pk_bf16_f32 v137, v118, v119
    v_add_f32 v138, v26, v34
    v_mov_b32 v139, s46
    v_cvt_pk_bf16_f32 v140, v120, v121
    v_cvt_pk_bf16_f32 v141, v122, v123
    v_add_f32 v142, v26, v34
    v_mov_b32 v143, s46
    v_cvt_pk_bf16_f32 v144, v124, v125
    v_cvt_pk_bf16_f32 v145, v126, v127
    v_add_f32 v146, v26, v34
    v_mov_b32 v147, s46
    s_branch L_NEXT
L_EMPTY:
    s_mul_i32 s3, s96, s31
    s_lshr_b32 s3, s3, 19
    s_cmp_ge_u32 s3, s32
    s_cbranch_scc1 L_DRAIN
    s_mov_b32 s37, s63
    s_mov_b32 s33, 0
    s_mov_b32 s35, 31
    s_mov_b32 s36, 32
    v_add_u32 v60, s63, v1
    v_mov_b32 v61, 0
    s_branch L_TBL
L_NOPG:
    s_cmp_lt_u32 s35, s36
    s_cbranch_scc1 L_NEXT
    s_waitcnt vmcnt(0)
    s_bitcmp1_b32 s2, 3
    s_cbranch_scc1 L_FLUSH
L_PISSUE:
    buffer_load_dwordx4 v[132:135], v152, s[56:59], s6 offen sc1
    buffer_load_dwordx4 v[136:139], v152, s[56:59], s7 offen sc1
    buffer_load_dwordx4 v[140:143], v152, s[56:59], s8 offen sc1
    buffer_load_dwordx4 v[144:147], v152, s[56:59], s9 offen sc1
    s_add_u32 s33, s33, 4
    s_cmp_eq_u32 s38, s37
    s_cbranch_scc0 L_PD
    s_branch L_FLUSH
L_MASK:
    s_cmp_eq_u32 s37, s39
    s_cselect_b32 s3, s40, 15
    v_sub_u32 v34, s3, v154
    s_cmp_eq_u32 s37, s43
    s_cselect_b32 s3, s42, 0
    v_cmp_le_u32 vcc, s3, v154
    s_cmp_eq_u32 s3, s3
    s_nop 0
    v_cndmask_b32 v34, -1, v34, vcc
    v_cmp_le_i32 s[88:89], 0, v34
    v_cmp_le_i32 s[90:91], 1, v34
    v_cmp_le_i32 s[92:93], 2, v34
    v_cmp_le_i32 s[94:95], 3, v34
    v_cndmask_b32 v28, v38, v28, s[88:89]
    v_cndmask_b32 v29, v38, v29, s[90:91]
    v_cndmask_b32 v30, v38, v30, s[92:93]
    v_cndmask_b32 v31, v38, v31, s[94:95]
    s_branch L_MASKD
L_MASK2:
    v_cndmask_b32 v28, v38, v28, s[88:89]
    v_cndmask_b32 v29, v38, v29, s[90:91]
    v_cndmask_b32 v30, v38, v30, s[92:93]
    v_cndmask_b32 v31, v38, v31, s[94:95]
    s_branch L_MASK2D
L_DRAIN:
    s_mov_b64 exec, -1
    s_waitcnt vmcnt(0)
L_EXIT:
s_endpgm
.section .rodata,"a"
.p2align 6
.amdhsa_kernel standalone__paged_block_table_kv_pagedattention__sampling_kernel
  .amdhsa_next_free_vgpr 164
  .amdhsa_next_free_sgpr 100
  .amdhsa_accum_offset 164
  .amdhsa_group_segment_fixed_size 0
  .amdhsa_kernarg_size 64
  .amdhsa_user_sgpr_count 2
  .amdhsa_user_sgpr_kernarg_segment_ptr 1
  .amdhsa_system_sgpr_workgroup_id_x 1
.end_amdhsa_kernel
```
